```python
import torch

def _softmax(x, axis=-1):
    return torch.softmax(x, dim=axis)

def _gelu(x):
    return torch.nn.functional.gelu(x, approximate='tanh')

def _silu(x):
    return torch.nn.functional.silu(x)

def _sigmoid(x):
    return torch.sigmoid(x)

def _layernorm(x, axis=-1, eps=1e-05):
    m = x.mean(dim=axis, keepdim=True)
    v = x.var(dim=axis, keepdim=True, unbiased=False)
    return (x - m) / torch.sqrt(v + eps)

def _scatter_add(tgt, idx, src, axis=0):
    return tgt.clone().index_add_(axis, idx, src)

def _segment_sum(src, seg, n):
    out = torch.zeros((n,) + src.shape[1:], dtype=src.dtype)
    return out.index_add_(0, seg, src)

def _pad(x, pw):
    flat = tuple((v for pair in reversed(pw) for v in pair))
    return torch.nn.functional.pad(x, flat)
kernel_name = 'standalone__tree_speculative_verify_tree_attention_over_candidate_token_tree__decode'

def setup_inputs():

    _w = lambda a: (lambda t: t.to(torch.bfloat16) if t.is_floating_point() else t)(torch.as_tensor(a))
    B, Hq, Hkv, T, C, D = (8, 32, 8, 1, 8192, 128)
    tree_mask = torch.zeros((B, T, T), dtype=float)
    for b in range(B):
        parent = torch.zeros(T, dtype=torch.int64)
        for i in range(1, T):
            parent[i] = int(torch.randint(0, i, (1,)).item())
        for i in range(T):
            j = i
            tree_mask[b, i, j] = 1.0
            while j > 0:
                j = parent[j]
                tree_mask[b, i, j] = 1.0
    return {'q': _w((lambda *s: torch.randn(*s, dtype=torch.bfloat16) * 0.8)(B, Hq, T, D)), 'k_cache': _w((lambda *s: torch.randn(*s, dtype=torch.bfloat16) * 0.8)(B, Hkv, C, D)), 'v_cache': _w((lambda *s: torch.randn(*s, dtype=torch.bfloat16) * 0.05)(B, Hkv, C, D)), 'k_tree': _w((lambda *s: torch.randn(*s, dtype=torch.bfloat16) * 0.8)(B, Hkv, T, D)), 'v_tree': _w((lambda *s: torch.randn(*s, dtype=torch.bfloat16) * 0.05)(B, Hkv, T, D)), 'tree_mask': _w(tree_mask)}

def reference(q, k_cache, v_cache, k_tree, v_tree, tree_mask):
    B, Hq, T, D = q.shape
    Hkv, C = (k_cache.shape[1], k_cache.shape[2])
    rep = Hq // Hkv
    kc = (lambda x, n, axis: torch.repeat_interleave(x, n, dim=axis))(k_cache, rep, axis=1)
    vc = (lambda x, n, axis: torch.repeat_interleave(x, n, dim=axis))(v_cache, rep, axis=1)
    kt = (lambda x, n, axis: torch.repeat_interleave(x, n, dim=axis))(k_tree, rep, axis=1)
    vt = (lambda x, n, axis: torch.repeat_interleave(x, n, dim=axis))(v_tree, rep, axis=1)
    k = torch.concatenate([kc, kt], axis=2)
    v = torch.concatenate([vc, vt], axis=2)
    scale = D ** (-0.5)
    scores = torch.einsum('bhqd,bhkd->bhqk', q, k) * scale
    ctx_mask = torch.ones((B, 1, T, C), dtype=scores.dtype)
    tm = tree_mask[:, None, :, :].clone()
    full_mask = torch.concatenate([ctx_mask, tm], axis=-1)
    scores = scores + (1.0 - full_mask) * -1000000000.0
    p = _softmax(scores, axis=-1)
    return torch.einsum('bhqk,bhkd->bhqd', p, v)
```

```asm
; @launch grid=(256,1,1) block=(64,1,1) lds=57344
.amdgcn_target "amdgcn-amd-amdhsa--gfx950"
.text
.globl standalone__tree_speculative_verify_tree_attention_over_candidate_token_tree__decode_kernel
.p2align 8
.type standalone__tree_speculative_verify_tree_attention_over_candidate_token_tree__decode_kernel,@function
standalone__tree_speculative_verify_tree_attention_over_candidate_token_tree__decode_kernel:
    s_cmp_ge_u32 s2, 256
    s_cbranch_scc1 L_done
    s_load_dwordx16 s[4:19], s[0:1], 0
    s_load_dwordx2 s[20:21], s[0:1], 64
    s_lshr_b32 s41, s2, 6
    s_lshl1_add_u32 s40, s41, s2
    s_and_b32 s40, s40, 63
    v_lshrrev_b32 v5, 4, v0
    v_lshlrev_b32 v4, 6, v5
    v_lshlrev_b32 v3, 4, v0
    v_xor_b32 v84, v4, v3
    v_xor_b32 v85, 16, v84
    v_xor_b32 v86, 32, v84
    v_xor_b32 v87, 48, v84
    s_lshl2_add_u32 s32, s40, s41
    s_lshl_b32 s32, s32, 19
    s_bitset1_b32 s32, 13
    s_mov_b32 s33, s32
    s_mov_b32 s26, 0x8000000
    s_mov_b32 s27, 0x20000
    s_mov_b32 s30, 0x8000000
    s_mov_b32 s31, 0x20000
    s_lshl_b32 s35, s40, 10
    s_waitcnt lgkmcnt(0)
    s_mov_b32 s24, s6
    s_and_b32 s25, s7, 0xffff
    s_mov_b32 m0, 0
    s_sub_u32 s34, s32, 8192
    buffer_load_dwordx4 v84, s[24:27], s34 offen offset:0 nt lds
    buffer_load_dwordx4 v85, s[24:27], s34 offen offset:1024 nt lds
    buffer_load_dwordx4 v86, s[24:27], s34 offen offset:2048 nt lds
    buffer_load_dwordx4 v87, s[24:27], s34 offen offset:3072 nt lds
    s_mov_b32 m0, 4096
    s_nop 0
    buffer_load_dwordx4 v84, s[24:27], s32 offen offset:0 nt lds
    buffer_load_dwordx4 v85, s[24:27], s32 offen offset:1024 nt lds
    buffer_load_dwordx4 v86, s[24:27], s32 offen offset:2048 nt lds
    buffer_load_dwordx4 v87, s[24:27], s32 offen offset:3072 nt lds
    s_add_u32 s32, s32, 0x1000
    s_bitset1_b32 s32, 13
    v_and_b32 v4, 3, v0
    v_lshlrev_b32 v4, 8, v4
    v_lshl_add_u32 v4, v5, 4, v4
    s_add_u32 s4, s4, s35
    s_addc_u32 s5, s5, 0
    s_mov_b32 s28, s8
    s_and_b32 s29, s9, 0xffff
    global_load_dwordx4 v[36:39], v4, s[4:5] offset:0
    global_load_dwordx4 v[40:43], v4, s[4:5] offset:64
    global_load_dwordx4 v[44:47], v4, s[4:5] offset:128
    global_load_dwordx4 v[48:51], v4, s[4:5] offset:192
    s_cmp_lg_u32 s41, 0
    s_cbranch_scc1 L_notree_ld
    s_lshl_b32 s35, s40, 8
    s_add_u32 s10, s10, s35
    s_addc_u32 s11, s11, 0
    s_add_u32 s12, s12, s35
    s_addc_u32 s13, s13, 0
    s_lshr_b32 s35, s40, 3
    s_lshl_b32 s35, s35, 1
    s_add_u32 s14, s14, s35
    s_addc_u32 s15, s15, 0
    v_lshlrev_b32 v4, 4, v5
    v_mov_b32 v10, 0
    v_and_b32 v9, 60, v0
    v_lshlrev_b32 v9, 2, v9
    global_load_dwordx4 v[12:15], v4, s[10:11] offset:0
    global_load_dwordx4 v[16:19], v4, s[10:11] offset:64
    global_load_dwordx4 v[20:23], v4, s[10:11] offset:128
    global_load_dwordx4 v[24:27], v4, s[10:11] offset:192
    global_load_dwordx4 v[124:127], v9, s[12:13]
    global_load_ushort v8, v10, s[14:15]
L_notree_ld:
    s_lshl_b32 s45, s40, 14
    s_add_u32 s20, s20, s45
    s_addc_u32 s21, s21, 0
    s_lshl_b32 s35, s40, 2
    s_add_u32 s18, s18, s35
    s_addc_u32 s19, s19, 0
    s_lshl_b32 s35, s40, 10
    s_add_u32 s16, s16, s35
    s_addc_u32 s17, s17, 0
    s_lshl_b32 s45, s41, 12
    v_add_u32 v11, s45, v3
    v_and_b32 v10, 15, v0
    v_lshl_add_u32 v10, v10, 3, s45
    v_mov_b32 v28, -1
    v_mov_b32 v29, -1
    v_mov_b32 v30, -1
    v_mov_b32 v31, -1
    global_store_dwordx4 v11, v[28:31], s[20:21] sc1
    global_store_dwordx4 v11, v[28:31], s[20:21] offset:1024 sc1
    s_mov_b64 exec, 0xffff
    global_store_dwordx2 v10, v[28:29], s[20:21] offset:2048 sc1
    s_mov_b64 exec, -1
    s_mov_b32 m0, 8192
    s_sub_u32 s34, s32, 8192
    buffer_load_dwordx4 v84, s[24:27], s34 offen offset:0 nt lds
    buffer_load_dwordx4 v85, s[24:27], s34 offen offset:1024 nt lds
    buffer_load_dwordx4 v86, s[24:27], s34 offen offset:2048 nt lds
    buffer_load_dwordx4 v87, s[24:27], s34 offen offset:3072 nt lds
    s_mov_b32 m0, 12288
    s_nop 0
    buffer_load_dwordx4 v84, s[24:27], s32 offen offset:0 nt lds
    buffer_load_dwordx4 v85, s[24:27], s32 offen offset:1024 nt lds
    buffer_load_dwordx4 v86, s[24:27], s32 offen offset:2048 nt lds
    buffer_load_dwordx4 v87, s[24:27], s32 offen offset:3072 nt lds
    s_add_u32 s32, s32, 0x1000
    s_bitset1_b32 s32, 13
    s_mov_b32 m0, 16384
    s_sub_u32 s34, s32, 8192
    buffer_load_dwordx4 v84, s[24:27], s34 offen offset:0 nt lds
    buffer_load_dwordx4 v85, s[24:27], s34 offen offset:1024 nt lds
    buffer_load_dwordx4 v86, s[24:27], s34 offen offset:2048 nt lds
    buffer_load_dwordx4 v87, s[24:27], s34 offen offset:3072 nt lds
    s_mov_b32 m0, 20480
    s_nop 0
    buffer_load_dwordx4 v84, s[24:27], s32 offen offset:0 nt lds
    buffer_load_dwordx4 v85, s[24:27], s32 offen offset:1024 nt lds
    buffer_load_dwordx4 v86, s[24:27], s32 offen offset:2048 nt lds
    buffer_load_dwordx4 v87, s[24:27], s32 offen offset:3072 nt lds
    s_add_u32 s32, s32, 0x1000
    s_bitset1_b32 s32, 13
    v_and_b32 v4, 3, v0
    v_bfe_u32 v9, v0, 2, 2
    v_lshlrev_b32 v88, 10, v4
    v_lshl_add_u32 v88, v9, 8, v88
    v_and_b32 v9, 15, v0
    v_xor_b32 v9, v9, v5
    v_lshl_add_u32 v88, v9, 4, v88
    v_xor_b32 v89, 64, v88
    v_xor_b32 v90, 0x80, v88
    v_xor_b32 v91, 0xc0, v88
    v_lshl_add_u32 v4, v5, 2, v4
    v_lshlrev_b32 v2, 4, v4
    v_add_u32 v2, 24576, v2
    s_mov_b32 s54, 0x000f000f
    s_mov_b32 s55, 0x000f000f
    s_mov_b32 s36, 0x3e0293ee
    s_mov_b32 s37, 0x05040100
    s_mov_b32 s38, 0x07060302
    v_mov_b32 v52, 0
    v_mov_b32 v53, 0
    v_mov_b32 v54, 0
    v_mov_b32 v55, 0
    v_mov_b32 v56, 0
    v_mov_b32 v57, 0
    v_mov_b32 v58, 0
    v_mov_b32 v59, 0
    v_mov_b32 v60, 0
    v_mov_b32 v61, 0
    v_mov_b32 v62, 0
    v_mov_b32 v63, 0
    v_mov_b32 v64, 0
    v_mov_b32 v65, 0
    v_mov_b32 v66, 0
    v_mov_b32 v67, 0
    v_mov_b32 v68, 0
    v_mov_b32 v69, 0
    v_mov_b32 v70, 0
    v_mov_b32 v71, 0
    v_mov_b32 v72, 0
    v_mov_b32 v73, 0
    v_mov_b32 v74, 0
    v_mov_b32 v75, 0
    v_mov_b32 v76, 0
    v_mov_b32 v77, 0
    v_mov_b32 v78, 0
    v_mov_b32 v79, 0
    v_mov_b32 v80, 0
    v_mov_b32 v81, 0
    v_mov_b32 v82, 0
    v_mov_b32 v83, 0
    v_mov_b32 v6, 0xff800000
    s_cmp_lg_u32 s41, 0
    s_cbranch_scc1 L_main
    s_waitcnt vmcnt(16)
    v_mfma_f32_16x16x32_bf16 v[28:31], v[12:15], v[36:39], 0
    v_mfma_f32_16x16x32_bf16 v[28:31], v[16:19], v[40:43], v[28:31]
    v_mfma_f32_16x16x32_bf16 v[28:31], v[20:23], v[44:47], v[28:31]
    v_mfma_f32_16x16x32_bf16 v[28:31], v[24:27], v[48:51], v[28:31]
    v_lshlrev_b32 v8, 16, v8
    v_sub_f32 v8, 1.0, v8
    v_mul_f32 v8, 0xceabfb8f, v8
    s_nop 4
    v_fma_f32 v6, v28, s36, v8
L_main:
    v_mov_b32 v24, 0xff800000
    s_mov_b32 s43, 20
L_kloop:
    s_waitcnt vmcnt(16)
    ds_read_b128 v[92:95], v88 offset:0
    ds_read_b128 v[108:111], v88 offset:4096
    ds_read_b128 v[96:99], v89 offset:0
    ds_read_b128 v[112:115], v89 offset:4096
    ds_read_b128 v[100:103], v90 offset:0
    ds_read_b128 v[116:119], v90 offset:4096
    ds_read_b128 v[104:107], v91 offset:0
    ds_read_b128 v[120:123], v91 offset:4096
    s_waitcnt lgkmcnt(6)
    v_mfma_f32_16x16x32_bf16 v[12:15], v[92:95], v[36:39], 0
    v_mfma_f32_16x16x32_bf16 v[16:19], v[108:111], v[36:39], 0
    s_waitcnt lgkmcnt(4)
    v_mfma_f32_16x16x32_bf16 v[12:15], v[96:99], v[40:43], v[12:15]
    v_mfma_f32_16x16x32_bf16 v[16:19], v[112:115], v[40:43], v[16:19]
    s_waitcnt lgkmcnt(2)
    v_mfma_f32_16x16x32_bf16 v[12:15], v[100:103], v[44:47], v[12:15]
    v_mfma_f32_16x16x32_bf16 v[16:19], v[116:119], v[44:47], v[16:19]
    s_waitcnt lgkmcnt(0)
    v_mfma_f32_16x16x32_bf16 v[12:15], v[104:107], v[48:51], v[12:15]
    v_mfma_f32_16x16x32_bf16 v[16:19], v[120:123], v[48:51], v[16:19]
    s_mov_b32 m0, 0
    s_sub_u32 s34, s32, 8192
    buffer_load_dwordx4 v84, s[24:27], s34 offen offset:0 nt lds
    buffer_load_dwordx4 v85, s[24:27], s34 offen offset:1024 nt lds
    buffer_load_dwordx4 v86, s[24:27], s34 offen offset:2048 nt lds
    buffer_load_dwordx4 v87, s[24:27], s34 offen offset:3072 nt lds
    s_mov_b32 m0, 4096
    s_nop 0
    buffer_load_dwordx4 v84, s[24:27], s32 offen offset:0 nt lds
    buffer_load_dwordx4 v85, s[24:27], s32 offen offset:1024 nt lds
    buffer_load_dwordx4 v86, s[24:27], s32 offen offset:2048 nt lds
    buffer_load_dwordx4 v87, s[24:27], s32 offen offset:3072 nt lds
    s_add_u32 s32, s32, 0x1000
    s_bitset1_b32 s32, 13
    s_mov_b64 exec, s[54:55]
    ds_write_b128 v2, v[12:15] offset:0
    ds_write_b128 v2, v[16:19] offset:256
    s_mov_b64 exec, -1
    v_max3_f32 v4, v12, v13, v14
    v_max3_f32 v5, v15, v16, v17
    v_max3_f32 v24, v24, v18, v19
    v_max3_f32 v24, v24, v4, v5
    s_waitcnt vmcnt(16)
    ds_read_b128 v[92:95], v88 offset:8192
    ds_read_b128 v[108:111], v88 offset:12288
    ds_read_b128 v[96:99], v89 offset:8192
    ds_read_b128 v[112:115], v89 offset:12288
    ds_read_b128 v[100:103], v90 offset:8192
    ds_read_b128 v[116:119], v90 offset:12288
    ds_read_b128 v[104:107], v91 offset:8192
    ds_read_b128 v[120:123], v91 offset:12288
    s_waitcnt lgkmcnt(6)
    v_mfma_f32_16x16x32_bf16 v[12:15], v[92:95], v[36:39], 0
    v_mfma_f32_16x16x32_bf16 v[16:19], v[108:111], v[36:39], 0
    s_waitcnt lgkmcnt(4)
    v_mfma_f32_16x16x32_bf16 v[12:15], v[96:99], v[40:43], v[12:15]
    v_mfma_f32_16x16x32_bf16 v[16:19], v[112:115], v[40:43], v[16:19]
    s_waitcnt lgkmcnt(2)
    v_mfma_f32_16x16x32_bf16 v[12:15], v[100:103], v[44:47], v[12:15]
    v_mfma_f32_16x16x32_bf16 v[16:19], v[116:119], v[44:47], v[16:19]
    s_waitcnt lgkmcnt(0)
    v_mfma_f32_16x16x32_bf16 v[12:15], v[104:107], v[48:51], v[12:15]
    v_mfma_f32_16x16x32_bf16 v[16:19], v[120:123], v[48:51], v[16:19]
    s_mov_b32 m0, 8192
    s_sub_u32 s34, s32, 8192
    buffer_load_dwordx4 v84, s[24:27], s34 offen offset:0 nt lds
    buffer_load_dwordx4 v85, s[24:27], s34 offen offset:1024 nt lds
    buffer_load_dwordx4 v86, s[24:27], s34 offen offset:2048 nt lds
    buffer_load_dwordx4 v87, s[24:27], s34 offen offset:3072 nt lds
    s_mov_b32 m0, 12288
    s_nop 0
    buffer_load_dwordx4 v84, s[24:27], s32 offen offset:0 nt lds
    buffer_load_dwordx4 v85, s[24:27], s32 offen offset:1024 nt lds
    buffer_load_dwordx4 v86, s[24:27], s32 offen offset:2048 nt lds
    buffer_load_dwordx4 v87, s[24:27], s32 offen offset:3072 nt lds
    s_add_u32 s32, s32, 0x1000
    s_bitset1_b32 s32, 13
    s_mov_b64 exec, s[54:55]
    ds_write_b128 v2, v[12:15] offset:512
    ds_write_b128 v2, v[16:19] offset:768
    s_mov_b64 exec, -1
    v_max3_f32 v4, v12, v13, v14
    v_max3_f32 v5, v15, v16, v17
    v_max3_f32 v24, v24, v18, v19
    v_max3_f32 v24, v24, v4, v5
    s_waitcnt vmcnt(16)
    ds_read_b128 v[92:95], v88 offset:16384
    ds_read_b128 v[108:111], v88 offset:20480
    ds_read_b128 v[96:99], v89 offset:16384
    ds_read_b128 v[112:115], v89 offset:20480
    ds_read_b128 v[100:103], v90 offset:16384
    ds_read_b128 v[116:119], v90 offset:20480
    ds_read_b128 v[104:107], v91 offset:16384
    ds_read_b128 v[120:123], v91 offset:20480
    s_waitcnt lgkmcnt(6)
    v_mfma_f32_16x16x32_bf16 v[12:15], v[92:95], v[36:39], 0
    v_mfma_f32_16x16x32_bf16 v[16:19], v[108:111], v[36:39], 0
    s_waitcnt lgkmcnt(4)
    v_mfma_f32_16x16x32_bf16 v[12:15], v[96:99], v[40:43], v[12:15]
    v_mfma_f32_16x16x32_bf16 v[16:19], v[112:115], v[40:43], v[16:19]
    s_waitcnt lgkmcnt(2)
    v_mfma_f32_16x16x32_bf16 v[12:15], v[100:103], v[44:47], v[12:15]
    v_mfma_f32_16x16x32_bf16 v[16:19], v[116:119], v[44:47], v[16:19]
    s_waitcnt lgkmcnt(0)
    v_mfma_f32_16x16x32_bf16 v[12:15], v[104:107], v[48:51], v[12:15]
    v_mfma_f32_16x16x32_bf16 v[16:19], v[120:123], v[48:51], v[16:19]
    s_mov_b32 m0, 16384
    s_sub_u32 s34, s32, 8192
    buffer_load_dwordx4 v84, s[24:27], s34 offen offset:0 nt lds
    buffer_load_dwordx4 v85, s[24:27], s34 offen offset:1024 nt lds
    buffer_load_dwordx4 v86, s[24:27], s34 offen offset:2048 nt lds
    buffer_load_dwordx4 v87, s[24:27], s34 offen offset:3072 nt lds
    s_mov_b32 m0, 20480
    s_nop 0
    buffer_load_dwordx4 v84, s[24:27], s32 offen offset:0 nt lds
    buffer_load_dwordx4 v85, s[24:27], s32 offen offset:1024 nt lds
    buffer_load_dwordx4 v86, s[24:27], s32 offen offset:2048 nt lds
    buffer_load_dwordx4 v87, s[24:27], s32 offen offset:3072 nt lds
    s_add_u32 s32, s32, 0x1000
    s_bitset1_b32 s32, 13
    s_mov_b64 exec, s[54:55]
    ds_write_b128 v2, v[12:15] offset:1024
    ds_write_b128 v2, v[16:19] offset:1280
    s_mov_b64 exec, -1
    v_max3_f32 v4, v12, v13, v14
    v_max3_f32 v5, v15, v16, v17
    v_max3_f32 v24, v24, v18, v19
    v_max3_f32 v24, v24, v4, v5
    v_add_u32 v2, 1536, v2
    s_sub_u32 s43, s43, 1
    s_cmp_lg_u32 s43, 0
    s_cbranch_scc1 L_kloop
    s_waitcnt vmcnt(16)
    ds_read_b128 v[92:95], v88 offset:0
    ds_read_b128 v[108:111], v88 offset:4096
    ds_read_b128 v[96:99], v89 offset:0
    ds_read_b128 v[112:115], v89 offset:4096
    ds_read_b128 v[100:103], v90 offset:0
    ds_read_b128 v[116:119], v90 offset:4096
    ds_read_b128 v[104:107], v91 offset:0
    ds_read_b128 v[120:123], v91 offset:4096
    s_waitcnt lgkmcnt(6)
    v_mfma_f32_16x16x32_bf16 v[12:15], v[92:95], v[36:39], 0
    v_mfma_f32_16x16x32_bf16 v[16:19], v[108:111], v[36:39], 0
    s_waitcnt lgkmcnt(4)
    v_mfma_f32_16x16x32_bf16 v[12:15], v[96:99], v[40:43], v[12:15]
    v_mfma_f32_16x16x32_bf16 v[16:19], v[112:115], v[40:43], v[16:19]
    s_waitcnt lgkmcnt(2)
    v_mfma_f32_16x16x32_bf16 v[12:15], v[100:103], v[44:47], v[12:15]
    v_mfma_f32_16x16x32_bf16 v[16:19], v[116:119], v[44:47], v[16:19]
    s_waitcnt lgkmcnt(0)
    v_mfma_f32_16x16x32_bf16 v[12:15], v[104:107], v[48:51], v[12:15]
    v_mfma_f32_16x16x32_bf16 v[16:19], v[120:123], v[48:51], v[16:19]
    s_mov_b32 m0, 0
    s_sub_u32 s34, s32, 8192
    buffer_load_dwordx4 v84, s[24:27], s34 offen offset:0 nt lds
    buffer_load_dwordx4 v85, s[24:27], s34 offen offset:1024 nt lds
    buffer_load_dwordx4 v86, s[24:27], s34 offen offset:2048 nt lds
    buffer_load_dwordx4 v87, s[24:27], s34 offen offset:3072 nt lds
    s_mov_b32 m0, 4096
    s_nop 0
    buffer_load_dwordx4 v84, s[24:27], s32 offen offset:0 nt lds
    buffer_load_dwordx4 v85, s[24:27], s32 offen offset:1024 nt lds
    buffer_load_dwordx4 v86, s[24:27], s32 offen offset:2048 nt lds
    buffer_load_dwordx4 v87, s[24:27], s32 offen offset:3072 nt lds
    s_add_u32 s32, s32, 0x1000
    s_bitset1_b32 s32, 13
    s_mov_b64 exec, s[54:55]
    ds_write_b128 v2, v[12:15] offset:0
    ds_write_b128 v2, v[16:19] offset:256
    s_mov_b64 exec, -1
    v_max3_f32 v4, v12, v13, v14
    v_max3_f32 v5, v15, v16, v17
    v_max3_f32 v24, v24, v18, v19
    v_max3_f32 v24, v24, v4, v5
    s_waitcnt vmcnt(16)
    ds_read_b128 v[92:95], v88 offset:8192
    ds_read_b128 v[108:111], v88 offset:12288
    ds_read_b128 v[96:99], v89 offset:8192
    ds_read_b128 v[112:115], v89 offset:12288
    ds_read_b128 v[100:103], v90 offset:8192
    ds_read_b128 v[116:119], v90 offset:12288
    ds_read_b128 v[104:107], v91 offset:8192
    ds_read_b128 v[120:123], v91 offset:12288
    s_waitcnt lgkmcnt(6)
    v_mfma_f32_16x16x32_bf16 v[12:15], v[92:95], v[36:39], 0
    v_mfma_f32_16x16x32_bf16 v[16:19], v[108:111], v[36:39], 0
    s_waitcnt lgkmcnt(4)
    v_mfma_f32_16x16x32_bf16 v[12:15], v[96:99], v[40:43], v[12:15]
    v_mfma_f32_16x16x32_bf16 v[16:19], v[112:115], v[40:43], v[16:19]
    s_waitcnt lgkmcnt(2)
    v_mfma_f32_16x16x32_bf16 v[12:15], v[100:103], v[44:47], v[12:15]
    v_mfma_f32_16x16x32_bf16 v[16:19], v[116:119], v[44:47], v[16:19]
    s_waitcnt lgkmcnt(0)
    v_mfma_f32_16x16x32_bf16 v[12:15], v[104:107], v[48:51], v[12:15]
    v_mfma_f32_16x16x32_bf16 v[16:19], v[120:123], v[48:51], v[16:19]
    s_sub_u32 s34, s33, 8192
    buffer_load_dwordx4 v[128:131], v3, s[28:31], s34 offen offset:0 nt
    buffer_load_dwordx4 v[132:135], v3, s[28:31], s34 offen offset:1024 nt
    buffer_load_dwordx4 v[136:139], v3, s[28:31], s34 offen offset:2048 nt
    buffer_load_dwordx4 v[140:143], v3, s[28:31], s34 offen offset:3072 nt
    buffer_load_dwordx4 v[144:147], v3, s[28:31], s33 offen offset:0 nt
    buffer_load_dwordx4 v[148:151], v3, s[28:31], s33 offen offset:1024 nt
    buffer_load_dwordx4 v[152:155], v3, s[28:31], s33 offen offset:2048 nt
    buffer_load_dwordx4 v[156:159], v3, s[28:31], s33 offen offset:3072 nt
    s_add_u32 s33, s33, 0x1000
    s_bitset1_b32 s33, 13
    s_mov_b64 exec, s[54:55]
    ds_write_b128 v2, v[12:15] offset:512
    ds_write_b128 v2, v[16:19] offset:768
    s_mov_b64 exec, -1
    v_max3_f32 v4, v12, v13, v14
    v_max3_f32 v5, v15, v16, v17
    v_max3_f32 v24, v24, v18, v19
    v_max3_f32 v24, v24, v4, v5
    s_waitcnt vmcnt(16)
    ds_read_b128 v[92:95], v88 offset:16384
    ds_read_b128 v[108:111], v88 offset:20480
    ds_read_b128 v[96:99], v89 offset:16384
    ds_read_b128 v[112:115], v89 offset:20480
    ds_read_b128 v[100:103], v90 offset:16384
    ds_read_b128 v[116:119], v90 offset:20480
    ds_read_b128 v[104:107], v91 offset:16384
    ds_read_b128 v[120:123], v91 offset:20480
    s_waitcnt lgkmcnt(6)
    v_mfma_f32_16x16x32_bf16 v[12:15], v[92:95], v[36:39], 0
    v_mfma_f32_16x16x32_bf16 v[16:19], v[108:111], v[36:39], 0
    s_waitcnt lgkmcnt(4)
    v_mfma_f32_16x16x32_bf16 v[12:15], v[96:99], v[40:43], v[12:15]
    v_mfma_f32_16x16x32_bf16 v[16:19], v[112:115], v[40:43], v[16:19]
    s_waitcnt lgkmcnt(2)
    v_mfma_f32_16x16x32_bf16 v[12:15], v[100:103], v[44:47], v[12:15]
    v_mfma_f32_16x16x32_bf16 v[16:19], v[116:119], v[44:47], v[16:19]
    s_waitcnt lgkmcnt(0)
    v_mfma_f32_16x16x32_bf16 v[12:15], v[104:107], v[48:51], v[12:15]
    v_mfma_f32_16x16x32_bf16 v[16:19], v[120:123], v[48:51], v[16:19]
    s_sub_u32 s34, s33, 8192
    buffer_load_dwordx4 v[160:163], v3, s[28:31], s34 offen offset:0 nt
    buffer_load_dwordx4 v[164:167], v3, s[28:31], s34 offen offset:1024 nt
    buffer_load_dwordx4 v[168:171], v3, s[28:31], s34 offen offset:2048 nt
    buffer_load_dwordx4 v[172:175], v3, s[28:31], s34 offen offset:3072 nt
    buffer_load_dwordx4 v[176:179], v3, s[28:31], s33 offen offset:0 nt
    buffer_load_dwordx4 v[180:183], v3, s[28:31], s33 offen offset:1024 nt
    buffer_load_dwordx4 v[184:187], v3, s[28:31], s33 offen offset:2048 nt
    buffer_load_dwordx4 v[188:191], v3, s[28:31], s33 offen offset:3072 nt
    s_add_u32 s33, s33, 0x1000
    s_bitset1_b32 s33, 13
    s_mov_b64 exec, s[54:55]
    ds_write_b128 v2, v[12:15] offset:1024
    ds_write_b128 v2, v[16:19] offset:1280
    s_mov_b64 exec, -1
    v_max3_f32 v4, v12, v13, v14
    v_max3_f32 v5, v15, v16, v17
    v_max3_f32 v24, v24, v18, v19
    v_max3_f32 v24, v24, v4, v5
    s_waitcnt vmcnt(16)
    ds_read_b128 v[92:95], v88 offset:0
    ds_read_b128 v[108:111], v88 offset:4096
    ds_read_b128 v[96:99], v89 offset:0
    ds_read_b128 v[112:115], v89 offset:4096
    ds_read_b128 v[100:103], v90 offset:0
    ds_read_b128 v[116:119], v90 offset:4096
    ds_read_b128 v[104:107], v91 offset:0
    ds_read_b128 v[120:123], v91 offset:4096
    s_waitcnt lgkmcnt(6)
    v_mfma_f32_16x16x32_bf16 v[12:15], v[92:95], v[36:39], 0
    v_mfma_f32_16x16x32_bf16 v[16:19], v[108:111], v[36:39], 0
    s_waitcnt lgkmcnt(4)
    v_mfma_f32_16x16x32_bf16 v[12:15], v[96:99], v[40:43], v[12:15]
    v_mfma_f32_16x16x32_bf16 v[16:19], v[112:115], v[40:43], v[16:19]
    s_waitcnt lgkmcnt(2)
    v_mfma_f32_16x16x32_bf16 v[12:15], v[100:103], v[44:47], v[12:15]
    v_mfma_f32_16x16x32_bf16 v[16:19], v[116:119], v[44:47], v[16:19]
    s_waitcnt lgkmcnt(0)
    v_mfma_f32_16x16x32_bf16 v[12:15], v[104:107], v[48:51], v[12:15]
    v_mfma_f32_16x16x32_bf16 v[16:19], v[120:123], v[48:51], v[16:19]
    s_sub_u32 s34, s33, 8192
    buffer_load_dwordx4 v[192:195], v3, s[28:31], s34 offen offset:0 nt
    buffer_load_dwordx4 v[196:199], v3, s[28:31], s34 offen offset:1024 nt
    buffer_load_dwordx4 v[200:203], v3, s[28:31], s34 offen offset:2048 nt
    buffer_load_dwordx4 v[204:207], v3, s[28:31], s34 offen offset:3072 nt
    buffer_load_dwordx4 v[208:211], v3, s[28:31], s33 offen offset:0 nt
    buffer_load_dwordx4 v[212:215], v3, s[28:31], s33 offen offset:1024 nt
    buffer_load_dwordx4 v[216:219], v3, s[28:31], s33 offen offset:2048 nt
    buffer_load_dwordx4 v[220:223], v3, s[28:31], s33 offen offset:3072 nt
    s_add_u32 s33, s33, 0x1000
    s_bitset1_b32 s33, 13
    s_mov_b64 exec, s[54:55]
    ds_write_b128 v2, v[12:15] offset:1536
    ds_write_b128 v2, v[16:19] offset:1792
    s_mov_b64 exec, -1
    v_max3_f32 v4, v12, v13, v14
    v_max3_f32 v5, v15, v16, v17
    v_max3_f32 v24, v24, v18, v19
    v_max3_f32 v24, v24, v4, v5
    v_mov_b32 v5, v24
    v_subrev_u32 v85, 30720, v2
    s_nop 0
    v_permlane32_swap_b32 v24, v5
    v_max_f32 v24, v24, v5
    v_mov_b32 v5, v24
    s_nop 1
    v_permlane16_swap_b32 v24, v5
    v_max_f32 v24, v24, v5
    v_mul_f32 v24, s36, v24
    v_max_f32 v9, v6, v24
    v_sub_f32 v8, v6, v9
    v_exp_f32 v8, v8
    v_mov_b32 v6, v9
    v_mul_f32 v7, 0x3e800000, v8
    s_cmp_lg_u32 s41, 0
    s_cbranch_scc1 L_vphase
    v_lshlrev_b32 v44, 16, v124
    v_and_b32 v45, 0xffff0000, v124
    v_lshlrev_b32 v46, 16, v125
    v_and_b32 v47, 0xffff0000, v125
    v_lshlrev_b32 v48, 16, v126
    v_and_b32 v49, 0xffff0000, v126
    v_lshlrev_b32 v50, 16, v127
    v_and_b32 v51, 0xffff0000, v127
    v_pk_mul_f32 v[44:45], v[44:45], v[8:9] op_sel_hi:[1,0]
    v_pk_mul_f32 v[46:47], v[46:47], v[8:9] op_sel_hi:[1,0]
    v_pk_mul_f32 v[48:49], v[48:49], v[8:9] op_sel_hi:[1,0]
    v_pk_mul_f32 v[50:51], v[50:51], v[8:9] op_sel_hi:[1,0]
L_vphase:
    s_mov_b32 s43, 15
L_vloop:
    ds_read_b128 v[12:15], v85 offset:0
    ds_read_b128 v[16:19], v85 offset:256
    s_waitcnt lgkmcnt(0)
    v_fma_f32 v12, v12, s36, -v6
    v_fma_f32 v13, v13, s36, -v6
    v_fma_f32 v14, v14, s36, -v6
    v_fma_f32 v15, v15, s36, -v6
    v_fma_f32 v16, v16, s36, -v6
    v_fma_f32 v17, v17, s36, -v6
    v_fma_f32 v18, v18, s36, -v6
    v_fma_f32 v19, v19, s36, -v6
    v_exp_f32 v12, v12
    v_exp_f32 v13, v13
    v_exp_f32 v14, v14
    v_exp_f32 v15, v15
    v_exp_f32 v16, v16
    v_exp_f32 v17, v17
    v_exp_f32 v18, v18
    v_exp_f32 v19, v19
    v_add_f32 v4, v12, v13
    v_cvt_pk_bf16_f32 v20, v12, v13
    v_cvt_pk_bf16_f32 v21, v14, v15
    v_cvt_pk_bf16_f32 v22, v16, v17
    v_cvt_pk_bf16_f32 v23, v18, v19
    v_add_f32 v5, v14, v15
    v_add_f32 v4, v4, v16
    v_add_f32 v5, v5, v17
    v_add_f32 v4, v4, v18
    v_add_f32 v5, v5, v19
    v_add_f32 v7, v7, v4
    v_add_f32 v7, v7, v5
    s_waitcnt vmcnt(16)
    v_perm_b32 v24, v132, v128, s37
    v_perm_b32 v25, v140, v136, s37
    v_perm_b32 v26, v148, v144, s37
    v_perm_b32 v27, v156, v152, s37
    v_perm_b32 v28, v132, v128, s38
    v_perm_b32 v29, v140, v136, s38
    v_perm_b32 v30, v148, v144, s38
    v_perm_b32 v31, v156, v152, s38
    v_mfma_f32_16x16x32_bf16 v[52:55], v[24:27], v[20:23], v[52:55]
    v_perm_b32 v32, v133, v129, s37
    v_perm_b32 v33, v141, v137, s37
    v_perm_b32 v34, v149, v145, s37
    v_perm_b32 v35, v157, v153, s37
    v_mfma_f32_16x16x32_bf16 v[56:59], v[28:31], v[20:23], v[56:59]
    v_perm_b32 v24, v133, v129, s38
    v_perm_b32 v25, v141, v137, s38
    v_perm_b32 v26, v149, v145, s38
    v_perm_b32 v27, v157, v153, s38
    v_mfma_f32_16x16x32_bf16 v[60:63], v[32:35], v[20:23], v[60:63]
    s_sub_u32 s34, s33, 8192
    buffer_load_dwordx4 v[224:227], v3, s[28:31], s34 offen offset:0 nt
    buffer_load_dwordx4 v[228:231], v3, s[28:31], s34 offen offset:1024 nt
    buffer_load_dwordx4 v[232:235], v3, s[28:31], s34 offen offset:2048 nt
    buffer_load_dwordx4 v[236:239], v3, s[28:31], s34 offen offset:3072 nt
    buffer_load_dwordx4 v[240:243], v3, s[28:31], s33 offen offset:0 nt
    buffer_load_dwordx4 v[244:247], v3, s[28:31], s33 offen offset:1024 nt
    buffer_load_dwordx4 v[248:251], v3, s[28:31], s33 offen offset:2048 nt
    buffer_load_dwordx4 v[252:255], v3, s[28:31], s33 offen offset:3072 nt
    s_add_u32 s33, s33, 0x1000
    s_bitset1_b32 s33, 13
    v_perm_b32 v28, v134, v130, s37
    v_perm_b32 v29, v142, v138, s37
    v_perm_b32 v30, v150, v146, s37
    v_perm_b32 v31, v158, v154, s37
    v_mfma_f32_16x16x32_bf16 v[64:67], v[24:27], v[20:23], v[64:67]
    v_perm_b32 v32, v134, v130, s38
    v_perm_b32 v33, v142, v138, s38
    v_perm_b32 v34, v150, v146, s38
    v_perm_b32 v35, v158, v154, s38
    v_mfma_f32_16x16x32_bf16 v[68:71], v[28:31], v[20:23], v[68:71]
    v_perm_b32 v24, v135, v131, s37
    v_perm_b32 v25, v143, v139, s37
    v_perm_b32 v26, v151, v147, s37
    v_perm_b32 v27, v159, v155, s37
    v_mfma_f32_16x16x32_bf16 v[72:75], v[32:35], v[20:23], v[72:75]
    v_perm_b32 v28, v135, v131, s38
    v_perm_b32 v29, v143, v139, s38
    v_perm_b32 v30, v151, v147, s38
    v_perm_b32 v31, v159, v155, s38
    v_mfma_f32_16x16x32_bf16 v[76:79], v[24:27], v[20:23], v[76:79]
    s_nop 1
    v_mfma_f32_16x16x32_bf16 v[80:83], v[28:31], v[20:23], v[80:83]
    ds_read_b128 v[12:15], v85 offset:512
    ds_read_b128 v[16:19], v85 offset:768
    s_waitcnt lgkmcnt(0)
    v_fma_f32 v12, v12, s36, -v6
    v_fma_f32 v13, v13, s36, -v6
    v_fma_f32 v14, v14, s36, -v6
    v_fma_f32 v15, v15, s36, -v6
    v_fma_f32 v16, v16, s36, -v6
    v_fma_f32 v17, v17, s36, -v6
    v_fma_f32 v18, v18, s36, -v6
    v_fma_f32 v19, v19, s36, -v6
    v_exp_f32 v12, v12
    v_exp_f32 v13, v13
    v_exp_f32 v14, v14
    v_exp_f32 v15, v15
    v_exp_f32 v16, v16
    v_exp_f32 v17, v17
    v_exp_f32 v18, v18
    v_exp_f32 v19, v19
    v_add_f32 v4, v12, v13
    v_cvt_pk_bf16_f32 v20, v12, v13
    v_cvt_pk_bf16_f32 v21, v14, v15
    v_cvt_pk_bf16_f32 v22, v16, v17
    v_cvt_pk_bf16_f32 v23, v18, v19
    v_add_f32 v5, v14, v15
    v_add_f32 v4, v4, v16
    v_add_f32 v5, v5, v17
    v_add_f32 v4, v4, v18
    v_add_f32 v5, v5, v19
    v_add_f32 v7, v7, v4
    v_add_f32 v7, v7, v5
    s_waitcnt vmcnt(16)
    v_perm_b32 v24, v164, v160, s37
    v_perm_b32 v25, v172, v168, s37
    v_perm_b32 v26, v180, v176, s37
    v_perm_b32 v27, v188, v184, s37
    v_perm_b32 v28, v164, v160, s38
    v_perm_b32 v29, v172, v168, s38
    v_perm_b32 v30, v180, v176, s38
    v_perm_b32 v31, v188, v184, s38
    v_mfma_f32_16x16x32_bf16 v[52:55], v[24:27], v[20:23], v[52:55]
    v_perm_b32 v32, v165, v161, s37
    v_perm_b32 v33, v173, v169, s37
    v_perm_b32 v34, v181, v177, s37
    v_perm_b32 v35, v189, v185, s37
    v_mfma_f32_16x16x32_bf16 v[56:59], v[28:31], v[20:23], v[56:59]
    v_perm_b32 v24, v165, v161, s38
    v_perm_b32 v25, v173, v169, s38
    v_perm_b32 v26, v181, v177, s38
    v_perm_b32 v27, v189, v185, s38
    v_mfma_f32_16x16x32_bf16 v[60:63], v[32:35], v[20:23], v[60:63]
    s_sub_u32 s34, s33, 8192
    buffer_load_dwordx4 v[128:131], v3, s[28:31], s34 offen offset:0 nt
    buffer_load_dwordx4 v[132:135], v3, s[28:31], s34 offen offset:1024 nt
    buffer_load_dwordx4 v[136:139], v3, s[28:31], s34 offen offset:2048 nt
    buffer_load_dwordx4 v[140:143], v3, s[28:31], s34 offen offset:3072 nt
    buffer_load_dwordx4 v[144:147], v3, s[28:31], s33 offen offset:0 nt
    buffer_load_dwordx4 v[148:151], v3, s[28:31], s33 offen offset:1024 nt
    buffer_load_dwordx4 v[152:155], v3, s[28:31], s33 offen offset:2048 nt
    buffer_load_dwordx4 v[156:159], v3, s[28:31], s33 offen offset:3072 nt
    s_add_u32 s33, s33, 0x1000
    s_bitset1_b32 s33, 13
    v_perm_b32 v28, v166, v162, s37
    v_perm_b32 v29, v174, v170, s37
    v_perm_b32 v30, v182, v178, s37
    v_perm_b32 v31, v190, v186, s37
    v_mfma_f32_16x16x32_bf16 v[64:67], v[24:27], v[20:23], v[64:67]
    v_perm_b32 v32, v166, v162, s38
    v_perm_b32 v33, v174, v170, s38
    v_perm_b32 v34, v182, v178, s38
    v_perm_b32 v35, v190, v186, s38
    v_mfma_f32_16x16x32_bf16 v[68:71], v[28:31], v[20:23], v[68:71]
    v_perm_b32 v24, v167, v163, s37
    v_perm_b32 v25, v175, v171, s37
    v_perm_b32 v26, v183, v179, s37
    v_perm_b32 v27, v191, v187, s37
    v_mfma_f32_16x16x32_bf16 v[72:75], v[32:35], v[20:23], v[72:75]
    v_perm_b32 v28, v167, v163, s38
    v_perm_b32 v29, v175, v171, s38
    v_perm_b32 v30, v183, v179, s38
    v_perm_b32 v31, v191, v187, s38
    v_mfma_f32_16x16x32_bf16 v[76:79], v[24:27], v[20:23], v[76:79]
    s_nop 1
    v_mfma_f32_16x16x32_bf16 v[80:83], v[28:31], v[20:23], v[80:83]
    ds_read_b128 v[12:15], v85 offset:1024
    ds_read_b128 v[16:19], v85 offset:1280
    s_waitcnt lgkmcnt(0)
    v_fma_f32 v12, v12, s36, -v6
    v_fma_f32 v13, v13, s36, -v6
    v_fma_f32 v14, v14, s36, -v6
    v_fma_f32 v15, v15, s36, -v6
    v_fma_f32 v16, v16, s36, -v6
    v_fma_f32 v17, v17, s36, -v6
    v_fma_f32 v18, v18, s36, -v6
    v_fma_f32 v19, v19, s36, -v6
    v_exp_f32 v12, v12
    v_exp_f32 v13, v13
    v_exp_f32 v14, v14
    v_exp_f32 v15, v15
    v_exp_f32 v16, v16
    v_exp_f32 v17, v17
    v_exp_f32 v18, v18
    v_exp_f32 v19, v19
    v_add_f32 v4, v12, v13
    v_cvt_pk_bf16_f32 v20, v12, v13
    v_cvt_pk_bf16_f32 v21, v14, v15
    v_cvt_pk_bf16_f32 v22, v16, v17
    v_cvt_pk_bf16_f32 v23, v18, v19
    v_add_f32 v5, v14, v15
    v_add_f32 v4, v4, v16
    v_add_f32 v5, v5, v17
    v_add_f32 v4, v4, v18
    v_add_f32 v5, v5, v19
    v_add_f32 v7, v7, v4
    v_add_f32 v7, v7, v5
    s_waitcnt vmcnt(16)
    v_perm_b32 v24, v196, v192, s37
    v_perm_b32 v25, v204, v200, s37
    v_perm_b32 v26, v212, v208, s37
    v_perm_b32 v27, v220, v216, s37
    v_perm_b32 v28, v196, v192, s38
    v_perm_b32 v29, v204, v200, s38
    v_perm_b32 v30, v212, v208, s38
    v_perm_b32 v31, v220, v216, s38
    v_mfma_f32_16x16x32_bf16 v[52:55], v[24:27], v[20:23], v[52:55]
    v_perm_b32 v32, v197, v193, s37
    v_perm_b32 v33, v205, v201, s37
    v_perm_b32 v34, v213, v209, s37
    v_perm_b32 v35, v221, v217, s37
    v_mfma_f32_16x16x32_bf16 v[56:59], v[28:31], v[20:23], v[56:59]
    v_perm_b32 v24, v197, v193, s38
    v_perm_b32 v25, v205, v201, s38
    v_perm_b32 v26, v213, v209, s38
    v_perm_b32 v27, v221, v217, s38
    v_mfma_f32_16x16x32_bf16 v[60:63], v[32:35], v[20:23], v[60:63]
    s_sub_u32 s34, s33, 8192
    buffer_load_dwordx4 v[160:163], v3, s[28:31], s34 offen offset:0 nt
    buffer_load_dwordx4 v[164:167], v3, s[28:31], s34 offen offset:1024 nt
    buffer_load_dwordx4 v[168:171], v3, s[28:31], s34 offen offset:2048 nt
    buffer_load_dwordx4 v[172:175], v3, s[28:31], s34 offen offset:3072 nt
    buffer_load_dwordx4 v[176:179], v3, s[28:31], s33 offen offset:0 nt
    buffer_load_dwordx4 v[180:183], v3, s[28:31], s33 offen offset:1024 nt
    buffer_load_dwordx4 v[184:187], v3, s[28:31], s33 offen offset:2048 nt
    buffer_load_dwordx4 v[188:191], v3, s[28:31], s33 offen offset:3072 nt
    s_add_u32 s33, s33, 0x1000
    s_bitset1_b32 s33, 13
    v_perm_b32 v28, v198, v194, s37
    v_perm_b32 v29, v206, v202, s37
    v_perm_b32 v30, v214, v210, s37
    v_perm_b32 v31, v222, v218, s37
    v_mfma_f32_16x16x32_bf16 v[64:67], v[24:27], v[20:23], v[64:67]
    v_perm_b32 v32, v198, v194, s38
    v_perm_b32 v33, v206, v202, s38
    v_perm_b32 v34, v214, v210, s38
    v_perm_b32 v35, v222, v218, s38
    v_mfma_f32_16x16x32_bf16 v[68:71], v[28:31], v[20:23], v[68:71]
    v_perm_b32 v24, v199, v195, s37
    v_perm_b32 v25, v207, v203, s37
    v_perm_b32 v26, v215, v211, s37
    v_perm_b32 v27, v223, v219, s37
    v_mfma_f32_16x16x32_bf16 v[72:75], v[32:35], v[20:23], v[72:75]
    v_perm_b32 v28, v199, v195, s38
    v_perm_b32 v29, v207, v203, s38
    v_perm_b32 v30, v215, v211, s38
    v_perm_b32 v31, v223, v219, s38
    v_mfma_f32_16x16x32_bf16 v[76:79], v[24:27], v[20:23], v[76:79]
    s_nop 1
    v_mfma_f32_16x16x32_bf16 v[80:83], v[28:31], v[20:23], v[80:83]
    ds_read_b128 v[12:15], v85 offset:1536
    ds_read_b128 v[16:19], v85 offset:1792
    s_waitcnt lgkmcnt(0)
    v_fma_f32 v12, v12, s36, -v6
    v_fma_f32 v13, v13, s36, -v6
    v_fma_f32 v14, v14, s36, -v6
    v_fma_f32 v15, v15, s36, -v6
    v_fma_f32 v16, v16, s36, -v6
    v_fma_f32 v17, v17, s36, -v6
    v_fma_f32 v18, v18, s36, -v6
    v_fma_f32 v19, v19, s36, -v6
    v_exp_f32 v12, v12
    v_exp_f32 v13, v13
    v_exp_f32 v14, v14
    v_exp_f32 v15, v15
    v_exp_f32 v16, v16
    v_exp_f32 v17, v17
    v_exp_f32 v18, v18
    v_exp_f32 v19, v19
    v_add_f32 v4, v12, v13
    v_cvt_pk_bf16_f32 v20, v12, v13
    v_cvt_pk_bf16_f32 v21, v14, v15
    v_cvt_pk_bf16_f32 v22, v16, v17
    v_cvt_pk_bf16_f32 v23, v18, v19
    v_add_f32 v5, v14, v15
    v_add_f32 v4, v4, v16
    v_add_f32 v5, v5, v17
    v_add_f32 v4, v4, v18
    v_add_f32 v5, v5, v19
    v_add_f32 v7, v7, v4
    v_add_f32 v7, v7, v5
    s_waitcnt vmcnt(16)
    v_perm_b32 v24, v228, v224, s37
    v_perm_b32 v25, v236, v232, s37
    v_perm_b32 v26, v244, v240, s37
    v_perm_b32 v27, v252, v248, s37
    v_perm_b32 v28, v228, v224, s38
    v_perm_b32 v29, v236, v232, s38
    v_perm_b32 v30, v244, v240, s38
    v_perm_b32 v31, v252, v248, s38
    v_mfma_f32_16x16x32_bf16 v[52:55], v[24:27], v[20:23], v[52:55]
    v_perm_b32 v32, v229, v225, s37
    v_perm_b32 v33, v237, v233, s37
    v_perm_b32 v34, v245, v241, s37
    v_perm_b32 v35, v253, v249, s37
    v_mfma_f32_16x16x32_bf16 v[56:59], v[28:31], v[20:23], v[56:59]
    v_perm_b32 v24, v229, v225, s38
    v_perm_b32 v25, v237, v233, s38
    v_perm_b32 v26, v245, v241, s38
    v_perm_b32 v27, v253, v249, s38
    v_mfma_f32_16x16x32_bf16 v[60:63], v[32:35], v[20:23], v[60:63]
    s_sub_u32 s34, s33, 8192
    buffer_load_dwordx4 v[192:195], v3, s[28:31], s34 offen offset:0 nt
    buffer_load_dwordx4 v[196:199], v3, s[28:31], s34 offen offset:1024 nt
    buffer_load_dwordx4 v[200:203], v3, s[28:31], s34 offen offset:2048 nt
    buffer_load_dwordx4 v[204:207], v3, s[28:31], s34 offen offset:3072 nt
    buffer_load_dwordx4 v[208:211], v3, s[28:31], s33 offen offset:0 nt
    buffer_load_dwordx4 v[212:215], v3, s[28:31], s33 offen offset:1024 nt
    buffer_load_dwordx4 v[216:219], v3, s[28:31], s33 offen offset:2048 nt
    buffer_load_dwordx4 v[220:223], v3, s[28:31], s33 offen offset:3072 nt
    s_add_u32 s33, s33, 0x1000
    s_bitset1_b32 s33, 13
    v_perm_b32 v28, v230, v226, s37
    v_perm_b32 v29, v238, v234, s37
    v_perm_b32 v30, v246, v242, s37
    v_perm_b32 v31, v254, v250, s37
    v_mfma_f32_16x16x32_bf16 v[64:67], v[24:27], v[20:23], v[64:67]
    v_perm_b32 v32, v230, v226, s38
    v_perm_b32 v33, v238, v234, s38
    v_perm_b32 v34, v246, v242, s38
    v_perm_b32 v35, v254, v250, s38
    v_mfma_f32_16x16x32_bf16 v[68:71], v[28:31], v[20:23], v[68:71]
    v_perm_b32 v24, v231, v227, s37
    v_perm_b32 v25, v239, v235, s37
    v_perm_b32 v26, v247, v243, s37
    v_perm_b32 v27, v255, v251, s37
    v_mfma_f32_16x16x32_bf16 v[72:75], v[32:35], v[20:23], v[72:75]
    v_perm_b32 v28, v231, v227, s38
    v_perm_b32 v29, v239, v235, s38
    v_perm_b32 v30, v247, v243, s38
    v_perm_b32 v31, v255, v251, s38
    v_mfma_f32_16x16x32_bf16 v[76:79], v[24:27], v[20:23], v[76:79]
    s_nop 1
    v_mfma_f32_16x16x32_bf16 v[80:83], v[28:31], v[20:23], v[80:83]
    v_add_u32 v85, 2048, v85
    s_sub_u32 s43, s43, 1
    s_cmp_lg_u32 s43, 0
    s_cbranch_scc1 L_vloop
    ds_read_b128 v[12:15], v85 offset:0
    ds_read_b128 v[16:19], v85 offset:256
    s_waitcnt lgkmcnt(0)
    v_fma_f32 v12, v12, s36, -v6
    v_fma_f32 v13, v13, s36, -v6
    v_fma_f32 v14, v14, s36, -v6
    v_fma_f32 v15, v15, s36, -v6
    v_fma_f32 v16, v16, s36, -v6
    v_fma_f32 v17, v17, s36, -v6
    v_fma_f32 v18, v18, s36, -v6
    v_fma_f32 v19, v19, s36, -v6
    v_exp_f32 v12, v12
    v_exp_f32 v13, v13
    v_exp_f32 v14, v14
    v_exp_f32 v15, v15
    v_exp_f32 v16, v16
    v_exp_f32 v17, v17
    v_exp_f32 v18, v18
    v_exp_f32 v19, v19
    v_add_f32 v4, v12, v13
    v_cvt_pk_bf16_f32 v20, v12, v13
    v_cvt_pk_bf16_f32 v21, v14, v15
    v_cvt_pk_bf16_f32 v22, v16, v17
    v_cvt_pk_bf16_f32 v23, v18, v19
    v_add_f32 v5, v14, v15
    v_add_f32 v4, v4, v16
    v_add_f32 v5, v5, v17
    v_add_f32 v4, v4, v18
    v_add_f32 v5, v5, v19
    v_add_f32 v7, v7, v4
    v_add_f32 v7, v7, v5
    s_waitcnt vmcnt(16)
    v_perm_b32 v24, v132, v128, s37
    v_perm_b32 v25, v140, v136, s37
    v_perm_b32 v26, v148, v144, s37
    v_perm_b32 v27, v156, v152, s37
    v_perm_b32 v28, v132, v128, s38
    v_perm_b32 v29, v140, v136, s38
    v_perm_b32 v30, v148, v144, s38
    v_perm_b32 v31, v156, v152, s38
    v_mfma_f32_16x16x32_bf16 v[52:55], v[24:27], v[20:23], v[52:55]
    v_perm_b32 v32, v133, v129, s37
    v_perm_b32 v33, v141, v137, s37
    v_perm_b32 v34, v149, v145, s37
    v_perm_b32 v35, v157, v153, s37
    v_mfma_f32_16x16x32_bf16 v[56:59], v[28:31], v[20:23], v[56:59]
    v_perm_b32 v24, v133, v129, s38
    v_perm_b32 v25, v141, v137, s38
    v_perm_b32 v26, v149, v145, s38
    v_perm_b32 v27, v157, v153, s38
    v_mfma_f32_16x16x32_bf16 v[60:63], v[32:35], v[20:23], v[60:63]
    s_sub_u32 s34, s33, 8192
    buffer_load_dwordx4 v[224:227], v3, s[28:31], s34 offen offset:0 nt
    buffer_load_dwordx4 v[228:231], v3, s[28:31], s34 offen offset:1024 nt
    buffer_load_dwordx4 v[232:235], v3, s[28:31], s34 offen offset:2048 nt
    buffer_load_dwordx4 v[236:239], v3, s[28:31], s34 offen offset:3072 nt
    buffer_load_dwordx4 v[240:243], v3, s[28:31], s33 offen offset:0 nt
    buffer_load_dwordx4 v[244:247], v3, s[28:31], s33 offen offset:1024 nt
    buffer_load_dwordx4 v[248:251], v3, s[28:31], s33 offen offset:2048 nt
    buffer_load_dwordx4 v[252:255], v3, s[28:31], s33 offen offset:3072 nt
    s_add_u32 s33, s33, 0x1000
    s_bitset1_b32 s33, 13
    v_perm_b32 v28, v134, v130, s37
    v_perm_b32 v29, v142, v138, s37
    v_perm_b32 v30, v150, v146, s37
    v_perm_b32 v31, v158, v154, s37
    v_mfma_f32_16x16x32_bf16 v[64:67], v[24:27], v[20:23], v[64:67]
    v_perm_b32 v32, v134, v130, s38
    v_perm_b32 v33, v142, v138, s38
    v_perm_b32 v34, v150, v146, s38
    v_perm_b32 v35, v158, v154, s38
    v_mfma_f32_16x16x32_bf16 v[68:71], v[28:31], v[20:23], v[68:71]
    v_perm_b32 v24, v135, v131, s37
    v_perm_b32 v25, v143, v139, s37
    v_perm_b32 v26, v151, v147, s37
    v_perm_b32 v27, v159, v155, s37
    v_mfma_f32_16x16x32_bf16 v[72:75], v[32:35], v[20:23], v[72:75]
    v_perm_b32 v28, v135, v131, s38
    v_perm_b32 v29, v143, v139, s38
    v_perm_b32 v30, v151, v147, s38
    v_perm_b32 v31, v159, v155, s38
    v_mfma_f32_16x16x32_bf16 v[76:79], v[24:27], v[20:23], v[76:79]
    s_nop 1
    v_mfma_f32_16x16x32_bf16 v[80:83], v[28:31], v[20:23], v[80:83]
    ds_read_b128 v[12:15], v85 offset:512
    ds_read_b128 v[16:19], v85 offset:768
    s_waitcnt lgkmcnt(0)
    v_fma_f32 v12, v12, s36, -v6
    v_fma_f32 v13, v13, s36, -v6
    v_fma_f32 v14, v14, s36, -v6
    v_fma_f32 v15, v15, s36, -v6
    v_fma_f32 v16, v16, s36, -v6
    v_fma_f32 v17, v17, s36, -v6
    v_fma_f32 v18, v18, s36, -v6
    v_fma_f32 v19, v19, s36, -v6
    v_exp_f32 v12, v12
    v_exp_f32 v13, v13
    v_exp_f32 v14, v14
    v_exp_f32 v15, v15
    v_exp_f32 v16, v16
    v_exp_f32 v17, v17
    v_exp_f32 v18, v18
    v_exp_f32 v19, v19
    v_add_f32 v4, v12, v13
    v_cvt_pk_bf16_f32 v20, v12, v13
    v_cvt_pk_bf16_f32 v21, v14, v15
    v_cvt_pk_bf16_f32 v22, v16, v17
    v_cvt_pk_bf16_f32 v23, v18, v19
    v_add_f32 v5, v14, v15
    v_add_f32 v4, v4, v16
    v_add_f32 v5, v5, v17
    v_add_f32 v4, v4, v18
    v_add_f32 v5, v5, v19
    v_add_f32 v7, v7, v4
    v_add_f32 v7, v7, v5
    s_waitcnt vmcnt(16)
    v_perm_b32 v24, v164, v160, s37
    v_perm_b32 v25, v172, v168, s37
    v_perm_b32 v26, v180, v176, s37
    v_perm_b32 v27, v188, v184, s37
    v_perm_b32 v28, v164, v160, s38
    v_perm_b32 v29, v172, v168, s38
    v_perm_b32 v30, v180, v176, s38
    v_perm_b32 v31, v188, v184, s38
    v_mfma_f32_16x16x32_bf16 v[52:55], v[24:27], v[20:23], v[52:55]
    v_perm_b32 v32, v165, v161, s37
    v_perm_b32 v33, v173, v169, s37
    v_perm_b32 v34, v181, v177, s37
    v_perm_b32 v35, v189, v185, s37
    v_mfma_f32_16x16x32_bf16 v[56:59], v[28:31], v[20:23], v[56:59]
    v_perm_b32 v24, v165, v161, s38
    v_perm_b32 v25, v173, v169, s38
    v_perm_b32 v26, v181, v177, s38
    v_perm_b32 v27, v189, v185, s38
    v_mfma_f32_16x16x32_bf16 v[60:63], v[32:35], v[20:23], v[60:63]
    v_perm_b32 v28, v166, v162, s37
    v_perm_b32 v29, v174, v170, s37
    v_perm_b32 v30, v182, v178, s37
    v_perm_b32 v31, v190, v186, s37
    v_mfma_f32_16x16x32_bf16 v[64:67], v[24:27], v[20:23], v[64:67]
    v_perm_b32 v32, v166, v162, s38
    v_perm_b32 v33, v174, v170, s38
    v_perm_b32 v34, v182, v178, s38
    v_perm_b32 v35, v190, v186, s38
    v_mfma_f32_16x16x32_bf16 v[68:71], v[28:31], v[20:23], v[68:71]
    v_perm_b32 v24, v167, v163, s37
    v_perm_b32 v25, v175, v171, s37
    v_perm_b32 v26, v183, v179, s37
    v_perm_b32 v27, v191, v187, s37
    v_mfma_f32_16x16x32_bf16 v[72:75], v[32:35], v[20:23], v[72:75]
    v_perm_b32 v28, v167, v163, s38
    v_perm_b32 v29, v175, v171, s38
    v_perm_b32 v30, v183, v179, s38
    v_perm_b32 v31, v191, v187, s38
    v_mfma_f32_16x16x32_bf16 v[76:79], v[24:27], v[20:23], v[76:79]
    s_nop 1
    v_mfma_f32_16x16x32_bf16 v[80:83], v[28:31], v[20:23], v[80:83]
    ds_read_b128 v[12:15], v85 offset:1024
    ds_read_b128 v[16:19], v85 offset:1280
    s_waitcnt lgkmcnt(0)
    s_mov_b32 s48, 1
    s_atomic_add s48, s[18:19], 0 glc
    v_fma_f32 v12, v12, s36, -v6
    v_fma_f32 v13, v13, s36, -v6
    v_fma_f32 v14, v14, s36, -v6
    v_fma_f32 v15, v15, s36, -v6
    v_fma_f32 v16, v16, s36, -v6
    v_fma_f32 v17, v17, s36, -v6
    v_fma_f32 v18, v18, s36, -v6
    v_fma_f32 v19, v19, s36, -v6
    v_exp_f32 v12, v12
    v_exp_f32 v13, v13
    v_exp_f32 v14, v14
    v_exp_f32 v15, v15
    v_exp_f32 v16, v16
    v_exp_f32 v17, v17
    v_exp_f32 v18, v18
    v_exp_f32 v19, v19
    v_add_f32 v4, v12, v13
    v_cvt_pk_bf16_f32 v20, v12, v13
    v_cvt_pk_bf16_f32 v21, v14, v15
    v_cvt_pk_bf16_f32 v22, v16, v17
    v_cvt_pk_bf16_f32 v23, v18, v19
    v_add_f32 v5, v14, v15
    v_add_f32 v4, v4, v16
    v_add_f32 v5, v5, v17
    v_add_f32 v4, v4, v18
    v_add_f32 v5, v5, v19
    v_add_f32 v7, v7, v4
    v_add_f32 v7, v7, v5
    s_waitcnt vmcnt(8)
    v_perm_b32 v24, v196, v192, s37
    v_perm_b32 v25, v204, v200, s37
    v_perm_b32 v26, v212, v208, s37
    v_perm_b32 v27, v220, v216, s37
    v_perm_b32 v28, v196, v192, s38
    v_perm_b32 v29, v204, v200, s38
    v_perm_b32 v30, v212, v208, s38
    v_perm_b32 v31, v220, v216, s38
    v_mfma_f32_16x16x32_bf16 v[52:55], v[24:27], v[20:23], v[52:55]
    v_perm_b32 v32, v197, v193, s37
    v_perm_b32 v33, v205, v201, s37
    v_perm_b32 v34, v213, v209, s37
    v_perm_b32 v35, v221, v217, s37
    v_mfma_f32_16x16x32_bf16 v[56:59], v[28:31], v[20:23], v[56:59]
    v_perm_b32 v24, v197, v193, s38
    v_perm_b32 v25, v205, v201, s38
    v_perm_b32 v26, v213, v209, s38
    v_perm_b32 v27, v221, v217, s38
    v_mfma_f32_16x16x32_bf16 v[60:63], v[32:35], v[20:23], v[60:63]
    v_perm_b32 v28, v198, v194, s37
    v_perm_b32 v29, v206, v202, s37
    v_perm_b32 v30, v214, v210, s37
    v_perm_b32 v31, v222, v218, s37
    v_mfma_f32_16x16x32_bf16 v[64:67], v[24:27], v[20:23], v[64:67]
    v_perm_b32 v32, v198, v194, s38
    v_perm_b32 v33, v206, v202, s38
    v_perm_b32 v34, v214, v210, s38
    v_perm_b32 v35, v222, v218, s38
    v_mfma_f32_16x16x32_bf16 v[68:71], v[28:31], v[20:23], v[68:71]
    v_perm_b32 v24, v199, v195, s37
    v_perm_b32 v25, v207, v203, s37
    v_perm_b32 v26, v215, v211, s37
    v_perm_b32 v27, v223, v219, s37
    v_mfma_f32_16x16x32_bf16 v[72:75], v[32:35], v[20:23], v[72:75]
    v_perm_b32 v28, v199, v195, s38
    v_perm_b32 v29, v207, v203, s38
    v_perm_b32 v30, v215, v211, s38
    v_perm_b32 v31, v223, v219, s38
    v_mfma_f32_16x16x32_bf16 v[76:79], v[24:27], v[20:23], v[76:79]
    s_nop 1
    v_mfma_f32_16x16x32_bf16 v[80:83], v[28:31], v[20:23], v[80:83]
    ds_read_b128 v[12:15], v85 offset:1536
    ds_read_b128 v[16:19], v85 offset:1792
    s_waitcnt lgkmcnt(0)
    v_fma_f32 v12, v12, s36, -v6
    v_fma_f32 v13, v13, s36, -v6
    v_fma_f32 v14, v14, s36, -v6
    v_fma_f32 v15, v15, s36, -v6
    v_fma_f32 v16, v16, s36, -v6
    v_fma_f32 v17, v17, s36, -v6
    v_fma_f32 v18, v18, s36, -v6
    v_fma_f32 v19, v19, s36, -v6
    v_exp_f32 v12, v12
    v_exp_f32 v13, v13
    v_exp_f32 v14, v14
    v_exp_f32 v15, v15
    v_exp_f32 v16, v16
    v_exp_f32 v17, v17
    v_exp_f32 v18, v18
    v_exp_f32 v19, v19
    v_add_f32 v4, v12, v13
    v_cvt_pk_bf16_f32 v20, v12, v13
    v_cvt_pk_bf16_f32 v21, v14, v15
    v_cvt_pk_bf16_f32 v22, v16, v17
    v_cvt_pk_bf16_f32 v23, v18, v19
    v_add_f32 v5, v14, v15
    v_add_f32 v4, v4, v16
    v_add_f32 v5, v5, v17
    v_add_f32 v4, v4, v18
    v_add_f32 v5, v5, v19
    v_add_f32 v7, v7, v4
    v_add_f32 v7, v7, v5
    v_mov_b32 v5, v7
    s_nop 1
    v_permlane32_swap_b32 v7, v5
    v_add_f32 v7, v7, v5
    v_mov_b32 v5, v7
    s_nop 1
    v_permlane16_swap_b32 v7, v5
    v_add_f32 v7, v7, v5
    s_waitcnt lgkmcnt(0)
    s_cmp_lg_u32 s48, 3
    s_cbranch_scc1 L_norem
    v_xor_b32 v4, 4096, v11
    v_xor_b32 v5, 4096, v10
    global_load_dwordx4 v[92:95], v4, s[20:21] sc1
    global_load_dwordx4 v[96:99], v4, s[20:21] offset:1024 sc1
    global_load_dwordx2 v[100:101], v5, s[20:21] offset:2048 sc1
    v_xor_b32 v4, 8192, v11
    v_xor_b32 v5, 8192, v10
    global_load_dwordx4 v[104:107], v4, s[20:21] sc1
    global_load_dwordx4 v[108:111], v4, s[20:21] offset:1024 sc1
    global_load_dwordx2 v[112:113], v5, s[20:21] offset:2048 sc1
    v_xor_b32 v4, 12288, v11
    v_xor_b32 v5, 12288, v10
    global_load_dwordx4 v[116:119], v4, s[20:21] sc1
    global_load_dwordx4 v[120:123], v4, s[20:21] offset:1024 sc1
    global_load_dwordx2 v[124:125], v5, s[20:21] offset:2048 sc1
    s_mov_b32 s45, 1
    s_waitcnt vmcnt(13)
    s_branch L_lastv
L_norem:
    s_mov_b32 s45, 0
    s_waitcnt vmcnt(4)
L_lastv:
    v_perm_b32 v24, v228, v224, s37
    v_perm_b32 v25, v236, v232, s37
    v_perm_b32 v28, v228, v224, s38
    v_perm_b32 v29, v236, v232, s38
    v_mfma_f32_16x16x16_bf16 v[52:55], v[24:25], v[20:21], v[52:55]
    v_perm_b32 v32, v229, v225, s37
    v_perm_b32 v33, v237, v233, s37
    v_mfma_f32_16x16x16_bf16 v[56:59], v[28:29], v[20:21], v[56:59]
    v_perm_b32 v24, v229, v225, s38
    v_perm_b32 v25, v237, v233, s38
    v_mfma_f32_16x16x16_bf16 v[60:63], v[32:33], v[20:21], v[60:63]
    v_perm_b32 v28, v230, v226, s37
    v_perm_b32 v29, v238, v234, s37
    v_mfma_f32_16x16x16_bf16 v[64:67], v[24:25], v[20:21], v[64:67]
    v_perm_b32 v32, v230, v226, s38
    v_perm_b32 v33, v238, v234, s38
    v_mfma_f32_16x16x16_bf16 v[68:71], v[28:29], v[20:21], v[68:71]
    v_perm_b32 v24, v231, v227, s37
    v_perm_b32 v25, v239, v235, s37
    v_mfma_f32_16x16x16_bf16 v[72:75], v[32:33], v[20:21], v[72:75]
    v_perm_b32 v28, v231, v227, s38
    v_perm_b32 v29, v239, v235, s38
    v_mfma_f32_16x16x16_bf16 v[76:79], v[24:25], v[20:21], v[76:79]
    s_nop 1
    v_mfma_f32_16x16x16_bf16 v[80:83], v[28:29], v[20:21], v[80:83]
    s_cmp_eq_u32 s45, 0
    s_cbranch_scc1 L_h0
    s_waitcnt vmcnt(9)
    s_branch L_h1
L_h0:
    s_waitcnt vmcnt(0)
L_h1:
    v_perm_b32 v24, v244, v240, s37
    v_perm_b32 v25, v252, v248, s37
    v_perm_b32 v28, v244, v240, s38
    v_perm_b32 v29, v252, v248, s38
    v_mfma_f32_16x16x16_bf16 v[52:55], v[24:25], v[22:23], v[52:55]
    v_perm_b32 v32, v245, v241, s37
    v_perm_b32 v33, v253, v249, s37
    v_mfma_f32_16x16x16_bf16 v[56:59], v[28:29], v[22:23], v[56:59]
    v_perm_b32 v24, v245, v241, s38
    v_perm_b32 v25, v253, v249, s38
    v_mfma_f32_16x16x16_bf16 v[60:63], v[32:33], v[22:23], v[60:63]
    v_perm_b32 v28, v246, v242, s37
    v_perm_b32 v29, v254, v250, s37
    v_mfma_f32_16x16x16_bf16 v[64:67], v[24:25], v[22:23], v[64:67]
    v_perm_b32 v32, v246, v242, s38
    v_perm_b32 v33, v254, v250, s38
    v_mfma_f32_16x16x16_bf16 v[68:71], v[28:29], v[22:23], v[68:71]
    v_perm_b32 v24, v247, v243, s37
    v_perm_b32 v25, v255, v251, s37
    v_mfma_f32_16x16x16_bf16 v[72:75], v[32:33], v[22:23], v[72:75]
    v_perm_b32 v28, v247, v243, s38
    v_perm_b32 v29, v255, v251, s38
    v_mfma_f32_16x16x16_bf16 v[76:79], v[24:25], v[22:23], v[76:79]
    s_nop 1
    v_mfma_f32_16x16x16_bf16 v[80:83], v[28:29], v[22:23], v[80:83]
    s_mov_b32 s50, 0xf0f0f0f0
    s_mov_b32 s51, 0xf0f0f0f0
    s_mov_b32 s52, 0xff00ff00
    s_mov_b32 s53, 0xff00ff00
    v_mov_b32 v20, v6
    v_mov_b32 v21, v7
    s_cmp_eq_u32 s48, 3
    s_nop 0
    v_cndmask_b32 v52, v52, v53, s[50:51]
    v_cndmask_b32 v54, v54, v55, s[50:51]
    v_cndmask_b32 v12, v52, v54, s[52:53]
    v_cndmask_b32 v56, v56, v57, s[50:51]
    v_cndmask_b32 v58, v58, v59, s[50:51]
    v_cndmask_b32 v13, v56, v58, s[52:53]
    v_cndmask_b32 v60, v60, v61, s[50:51]
    v_cndmask_b32 v62, v62, v63, s[50:51]
    v_cndmask_b32 v14, v60, v62, s[52:53]
    v_cndmask_b32 v64, v64, v65, s[50:51]
    v_cndmask_b32 v66, v66, v67, s[50:51]
    v_cndmask_b32 v15, v64, v66, s[52:53]
    v_cndmask_b32 v68, v68, v69, s[50:51]
    v_cndmask_b32 v70, v70, v71, s[50:51]
    v_cndmask_b32 v16, v68, v70, s[52:53]
    v_cndmask_b32 v72, v72, v73, s[50:51]
    v_cndmask_b32 v74, v74, v75, s[50:51]
    v_cndmask_b32 v17, v72, v74, s[52:53]
    v_cndmask_b32 v76, v76, v77, s[50:51]
    v_cndmask_b32 v78, v78, v79, s[50:51]
    v_cndmask_b32 v18, v76, v78, s[52:53]
    v_cndmask_b32 v80, v80, v81, s[50:51]
    v_cndmask_b32 v82, v82, v83, s[50:51]
    v_cndmask_b32 v19, v80, v82, s[52:53]
    s_cmp_lg_u32 s41, 0
    s_cbranch_scc1 L_notw
    v_pk_add_f32 v[12:13], v[12:13], v[44:45]
    v_pk_add_f32 v[14:15], v[14:15], v[46:47]
    v_pk_add_f32 v[16:17], v[16:17], v[48:49]
    v_pk_add_f32 v[18:19], v[18:19], v[50:51]
L_notw:
    s_cmp_eq_u32 s48, 3
    s_cbranch_scc1 L_consumer
    v_min_u32 v12, -2, v12
    v_min_u32 v13, -2, v13
    v_min_u32 v14, -2, v14
    v_min_u32 v15, -2, v15
    v_min_u32 v16, -2, v16
    v_min_u32 v17, -2, v17
    v_min_u32 v18, -2, v18
    v_min_u32 v19, -2, v19
    v_min_u32 v20, -2, v20
    v_min_u32 v21, -2, v21
    global_store_dwordx4 v11, v[12:15], s[20:21] sc1
    global_store_dwordx4 v11, v[16:19], s[20:21] offset:1024 sc1
    s_mov_b64 exec, 0xffff
    global_store_dwordx2 v10, v[20:21], s[20:21] offset:2048 sc1
    s_branch L_fin
L_consumer:
    s_mov_b32 s45, 0x400000
    v_and_b32 v2, 3, v0
    v_lshlrev_b32 v2, 8, v2
    v_and_b32 v9, 60, v0
    v_lshl_add_u32 v2, v9, 2, v2
L_poll:
    s_waitcnt vmcnt(0)
    v_max3_u32 v4, v92, v93, v94
    v_max3_u32 v5, v95, v96, v97
    v_max3_u32 v4, v4, v98, v99
    v_max3_u32 v5, v5, v100, v101
    v_max3_u32 v4, v4, v104, v105
    v_max3_u32 v5, v5, v106, v107
    v_max3_u32 v4, v4, v108, v109
    v_max3_u32 v5, v5, v110, v111
    v_max3_u32 v4, v4, v112, v113
    v_max3_u32 v5, v5, v116, v117
    v_max3_u32 v4, v4, v118, v119
    v_max3_u32 v5, v5, v120, v121
    v_max3_u32 v4, v4, v122, v123
    v_max3_u32 v5, v5, v124, v125
    v_max_u32 v4, v4, v5
    v_cmp_eq_u32 vcc, -1, v4
    s_cbranch_vccz L_ready
    s_sub_u32 s45, s45, 1
    s_cbranch_scc1 L_ready
    v_xor_b32 v4, 4096, v11
    v_xor_b32 v5, 4096, v10
    global_load_dwordx4 v[92:95], v4, s[20:21] sc1
    global_load_dwordx4 v[96:99], v4, s[20:21] offset:1024 sc1
    global_load_dwordx2 v[100:101], v5, s[20:21] offset:2048 sc1
    v_xor_b32 v4, 8192, v11
    v_xor_b32 v5, 8192, v10
    global_load_dwordx4 v[104:107], v4, s[20:21] sc1
    global_load_dwordx4 v[108:111], v4, s[20:21] offset:1024 sc1
    global_load_dwordx2 v[112:113], v5, s[20:21] offset:2048 sc1
    v_xor_b32 v4, 12288, v11
    v_xor_b32 v5, 12288, v10
    global_load_dwordx4 v[116:119], v4, s[20:21] sc1
    global_load_dwordx4 v[120:123], v4, s[20:21] offset:1024 sc1
    global_load_dwordx2 v[124:125], v5, s[20:21] offset:2048 sc1
    s_branch L_poll
L_ready:
    v_max3_f32 v4, v20, v100, v112
    v_max_f32 v4, v4, v124
    v_sub_f32 v20, v20, v4
    v_sub_f32 v100, v100, v4
    v_sub_f32 v112, v112, v4
    v_sub_f32 v124, v124, v4
    v_exp_f32 v20, v20
    v_exp_f32 v100, v100
    v_exp_f32 v112, v112
    v_exp_f32 v124, v124
    v_mul_f32 v5, v21, v20
    v_fmac_f32 v5, v101, v100
    v_fmac_f32 v5, v113, v112
    v_fmac_f32 v5, v125, v124
    v_rcp_f32 v5, v5
    v_pk_mul_f32 v[12:13], v[12:13], v[20:21] op_sel_hi:[1,0]
    v_pk_mul_f32 v[14:15], v[14:15], v[20:21] op_sel_hi:[1,0]
    v_pk_mul_f32 v[16:17], v[16:17], v[20:21] op_sel_hi:[1,0]
    v_pk_mul_f32 v[18:19], v[18:19], v[20:21] op_sel_hi:[1,0]
    v_pk_fma_f32 v[12:13], v[92:93], v[100:101], v[12:13] op_sel_hi:[1,0,1]
    v_pk_fma_f32 v[14:15], v[94:95], v[100:101], v[14:15] op_sel_hi:[1,0,1]
    v_pk_fma_f32 v[16:17], v[96:97], v[100:101], v[16:17] op_sel_hi:[1,0,1]
    v_pk_fma_f32 v[18:19], v[98:99], v[100:101], v[18:19] op_sel_hi:[1,0,1]
    v_pk_fma_f32 v[12:13], v[104:105], v[112:113], v[12:13] op_sel_hi:[1,0,1]
    v_pk_fma_f32 v[14:15], v[106:107], v[112:113], v[14:15] op_sel_hi:[1,0,1]
    v_pk_fma_f32 v[16:17], v[108:109], v[112:113], v[16:17] op_sel_hi:[1,0,1]
    v_pk_fma_f32 v[18:19], v[110:111], v[112:113], v[18:19] op_sel_hi:[1,0,1]
    v_pk_fma_f32 v[12:13], v[116:117], v[124:125], v[12:13] op_sel_hi:[1,0,1]
    v_pk_fma_f32 v[14:15], v[118:119], v[124:125], v[14:15] op_sel_hi:[1,0,1]
    v_pk_fma_f32 v[16:17], v[120:121], v[124:125], v[16:17] op_sel_hi:[1,0,1]
    v_pk_fma_f32 v[18:19], v[122:123], v[124:125], v[18:19] op_sel_hi:[1,0,1]
    v_pk_mul_f32 v[12:13], v[12:13], v[4:5] op_sel:[0,1] op_sel_hi:[1,1]
    v_pk_mul_f32 v[14:15], v[14:15], v[4:5] op_sel:[0,1] op_sel_hi:[1,1]
    v_pk_mul_f32 v[16:17], v[16:17], v[4:5] op_sel:[0,1] op_sel_hi:[1,1]
    v_pk_mul_f32 v[18:19], v[18:19], v[4:5] op_sel:[0,1] op_sel_hi:[1,1]
    v_cvt_pk_bf16_f32 v12, v12, v13
    v_cvt_pk_bf16_f32 v13, v14, v15
    v_cvt_pk_bf16_f32 v14, v16, v17
    v_cvt_pk_bf16_f32 v15, v18, v19
    global_store_dwordx4 v2, v[12:15], s[16:17] sc1
L_fin:
L_done:
    s_endpgm
.section .rodata,"a"
.p2align 6
.amdhsa_kernel standalone__tree_speculative_verify_tree_attention_over_candidate_token_tree__decode_kernel
  .amdhsa_next_free_vgpr 256
  .amdhsa_next_free_sgpr 72
  .amdhsa_accum_offset 256
  .amdhsa_group_segment_fixed_size 0
  .amdhsa_kernarg_size 72
  .amdhsa_user_sgpr_count 2
  .amdhsa_user_sgpr_kernarg_segment_ptr 1
  .amdhsa_system_sgpr_workgroup_id_x 1
.end_amdhsa_kernel
```
